```python
import torch

def _softmax(x, axis=-1):
    return torch.softmax(x, dim=axis)
def _gelu(x):
    return torch.nn.functional.gelu(x, approximate="tanh")
def _silu(x):
    return torch.nn.functional.silu(x)
def _sigmoid(x):
    return torch.sigmoid(x)
def _layernorm(x, axis=-1, eps=1e-5):
    m = x.mean(dim=axis, keepdim=True)
    v = x.var(dim=axis, keepdim=True, unbiased=False)
    return (x - m) / torch.sqrt(v + eps)
def _scatter_add(tgt, idx, src, axis=0):
    return tgt.clone().index_add_(axis, idx, src)
def _segment_sum(src, seg, n):
    out = torch.zeros((n,) + src.shape[1:], dtype=src.dtype)
    return out.index_add_(0, seg, src)
def _pad(x, pw):
    flat = tuple(v for pair in reversed(pw) for v in pair)
    return torch.nn.functional.pad(x, flat)

kernel_name = 'recurrent_scan__sliding_block_cached__mixer_channel_mlp__decode'

def setup_inputs():

    _w = (lambda a: (lambda t: t.to(torch.bfloat16) if t.is_floating_point() else t)(torch.as_tensor(a)))
    def _A_setup():
        B, Sq, D = 1, 1, 512
        Hq, Hkv, Sk, Dh = 32, 8, 32768, 128
        assert Hq % Hkv == 0, (Hq, Hkv)
        return {
            "x": _w((lambda *s: torch.randn(*s, dtype=torch.bfloat16) * 0.1)(B, Sq, D)),
            "k_cache": _w((lambda *s: torch.randn(*s, dtype=torch.bfloat16) * 0.8)(B, Hkv, Sk, Dh)),
            "v_cache": _w((lambda *s: torch.randn(*s, dtype=torch.bfloat16) * 3.2)(B, Hkv, Sk, Dh)),
            "wq": _w((lambda *s: torch.randn(*s, dtype=torch.bfloat16) * 0.8)(D, Hq * Dh) * (D ** -0.5)),
            "wo": _w((lambda *s: torch.randn(*s, dtype=torch.bfloat16) * 3.2)(Hq * Dh, D) * ((Hq * Dh) ** -0.5)),
        }
    _A_in = _A_setup()

    def _B_setup():
        B, S, D, F = 1, 1, 512, 1792
        return {
            "x": _w((lambda *s: torch.randn(*s, dtype=torch.bfloat16) * 0.1)(B, S, D)),
            "w1": _w((lambda *s: torch.randn(*s, dtype=torch.bfloat16) * 3.2)(D, F) * (D ** -0.5)),
            "b1": _w((lambda *s: torch.randn(*s, dtype=torch.bfloat16) * 3.2)(F)),
            "w2": _w((lambda *s: torch.randn(*s, dtype=torch.bfloat16) * 3.2)(F, D) * (F ** -0.5)),
            "b2": _w((lambda *s: torch.randn(*s, dtype=torch.bfloat16) * 3.2)(D)),
        }
    _B_in = _B_setup()

    return {
        "A_x": _A_in["x"],
        "A_k_cache": _A_in["k_cache"],
        "A_v_cache": _A_in["v_cache"],
        "A_wq": _A_in["wq"],
        "A_wo": _A_in["wo"],
        "B_x": _B_in["x"],
        "B_w1": _B_in["w1"],
        "B_b1": _B_in["b1"],
        "B_w2": _B_in["w2"],
        "B_b2": _B_in["b2"],
    }

def reference(A_x, A_k_cache, A_v_cache, A_wq, A_wo, B_x, B_w1, B_b1, B_w2, B_b2):
    def _A_ref(x, k_cache, v_cache, wq, wo):
        B, Sq, D = x.shape
        Hq, Dh = 32, 128
        Hkv, Sk = k_cache.shape[1], k_cache.shape[2]
        W = min(4096, max(256, Sk // 4))
        rep = Hq // Hkv
        q = (lambda x, *d: x.permute(*d))((x @ wq).reshape(B, Sq, Hq, Dh), 0, 2, 1, 3)
        k = (lambda x, n, axis: torch.repeat_interleave(x, n, dim=axis))(k_cache[:, :, Sk - W:, :], rep, axis=1)
        v = (lambda x, n, axis: torch.repeat_interleave(x, n, dim=axis))(v_cache[:, :, Sk - W:, :], rep, axis=1)
        scores = torch.einsum("bhqd,bhkd->bhqk", q, k) * (Dh ** -0.5)
        p = _softmax(scores, axis=-1)
        o = torch.einsum("bhqk,bhkd->bhqd", p, v)
        return (lambda x, *d: x.permute(*d))(o, 0, 2, 1, 3).reshape(B, Sq, Hq * Dh) @ wo

    def _B_ref(x, w1, b1, w2, b2):
        y = _layernorm(x, axis=-1)
        h = _gelu(torch.einsum("bsd,df->bsf", y, w1) + b1)
        return torch.einsum("bsf,fd->bsd", h, w2) + b2

    x = A_x
    xn = _layernorm(x, axis=-1)
    s = _A_ref(xn, A_k_cache, A_v_cache, A_wq, A_wo)
    g = _silu(_B_ref(xn, B_w1, B_b1, B_w2, B_b2))
    return x + s * g
```

```asm
; @launch grid=(256,1,1) block=(384,1,1) lds=131200
.amdgcn_target "amdgcn-amd-amdhsa--gfx950"
.text
.globl recurrent_scan__sliding_block_cached__mixer_channel_mlp__decode_kernel
.p2align 13
.fill 0x700, 4, 0xbf810000
.p2align 8
.type recurrent_scan__sliding_block_cached__mixer_channel_mlp__decode_kernel,@function
recurrent_scan__sliding_block_cached__mixer_channel_mlp__decode_kernel:
    s_load_dwordx16 s[4:19], s[0:1], 0
    s_load_dwordx8 s[20:27], s[0:1], 64
    s_load_dwordx2 s[28:29], s[0:1], 96
    v_readfirstlane_b32 s32, v0
    s_lshr_b32 s31, s2, 3
    s_cmp_ge_u32 s31, 32
    s_cbranch_scc1 L_exit
    s_and_b32 s30, s2, 7
    s_lshr_b32 s34, s31, 3
    s_and_b32 s35, s31, 7
    s_lshr_b32 s32, s32, 6
    s_cmp_eq_u32 s32, 1
    s_cbranch_scc1 L_pad1
    s_cmp_eq_u32 s32, 5
    s_cbranch_scc1 L_aux
    s_cmp_lg_u32 s32, 0
    s_cbranch_scc1 L_comp
    v_lshrrev_b32 v4, 3, v0
    v_and_b32 v5, 7, v0
    v_and_b32 v6, 2, v4
    v_xor_b32 v5, v5, v6
    v_lshlrev_b32 v5, 4, v5
    s_lshl_b32 s37, s34, 20
    s_lshl_b32 s38, s30, 10
    s_lshl_b32 s39, s35, 7
    s_add_u32 s37, s37, s38
    s_add_u32 s37, s37, s39
    v_lshl_add_u32 v10, v4, 13, v5
    v_add_u32 v10, s37, v10
    s_movk_i32 s50, 1088
    s_lshl_b32 s51, 1, 16
    s_mov_b32 m0, 0
    v_lshlrev_b32 v9, 4, v0
    s_setprio 3
    s_waitcnt lgkmcnt(0)
    global_load_lds_dwordx4 v9, s[4:5]
    s_add_u32 m0, m0, s50
    s_nop 0
L_ldq:
    global_load_lds_dwordx4 v10, s[10:11] nt
    s_add_u32 m0, m0, s50
    v_add_u32 v10, s51, v10
    global_load_lds_dwordx4 v10, s[10:11] nt
    s_add_u32 m0, m0, s50
    v_add_u32 v10, s51, v10
    s_cmpk_lt_u32 m0, 18496
    s_cbranch_scc1 L_ldq
    s_lshl_b32 s36, s30, 2
    s_add_u32 s36, s36, s34
    s_cmp_ge_u32 s30, 7
    s_branch L_po1
    .p2align 8,,64
L_pad1:
    s_branch L_comp
L_po1:
    s_cselect_b32 s46, 4, 0
    s_sub_u32 s46, s36, s46
    s_cmp_lg_u32 s30, 7
    s_cselect_b64 s[48:49], -1, 1
    v_mov_b32 v3, 122944
    v_lshl_add_u32 v3, v0, 2, v3
    s_mul_i32 s37, s35, 64*3584
    s_lshl_b32 s38, s46, 7
    s_add_u32 s37, s37, s38
    v_mul_u32_u24 v11, 3584, v4
    v_add3_u32 v11, v11, v5, s37
    s_movk_i32 s51, 28672
    s_mov_b64 exec, s[48:49]
    global_load_lds_dwordx4 v11, s[16:17] nt
    s_add_u32 m0, m0, s50
    v_add_u32 v11, s51, v11
    global_load_lds_dwordx4 v11, s[16:17] nt
    s_add_u32 m0, m0, s50
    v_add_u32 v11, s51, v11
    global_load_lds_dwordx4 v11, s[16:17] nt
    s_add_u32 m0, m0, s50
    v_add_u32 v11, s51, v11
    global_load_lds_dwordx4 v11, s[16:17] nt
    s_add_u32 m0, m0, s50
    v_add_u32 v11, s51, v11
    s_waitcnt vmcnt(20)
    s_barrier
    v_mov_b32 v7, 4
L_ld1:
    s_waitcnt vmcnt(19)
    global_load_lds_dwordx4 v11, s[16:17] nt
    s_add_u32 m0, m0, s50
    v_add_u32 v11, s51, v11
    s_waitcnt vmcnt(19)
    global_load_lds_dwordx4 v11, s[16:17] nt
    s_add_u32 m0, m0, s50
    v_add_u32 v11, s51, v11
    s_waitcnt vmcnt(19)
    global_load_lds_dwordx4 v11, s[16:17] nt
    s_add_u32 m0, m0, s50
    v_add_u32 v11, s51, v11
    s_waitcnt vmcnt(19)
    ds_max_i32 v3, v7
    global_load_lds_dwordx4 v11, s[16:17] nt
    s_add_u32 m0, m0, s50
    v_add_u32 v11, s51, v11
    v_add_u32 v7, 4, v7
    s_cmpk_lt_u32 m0, 27200
    s_cbranch_scc1 L_ld1
    s_mov_b64 exec, -1
    s_lshl_b32 s37, s30, 23
    s_lshl_b32 s38, s31, 15
    s_add_u32 s37, s37, s38
    s_add_u32 s47, s37, 0x700000
    v_lshrrev_b32 v8, 4, v0
    v_and_b32 v9, 15, v0
    v_xor_b32 v6, v9, v8
    v_lshlrev_b32 v6, 4, v6
    v_lshl_add_u32 v12, v8, 8, v6
    s_mul_i32 s37, s31, 3
    s_mul_i32 s38, s30, 1
    s_add_u32 s37, s37, s38
    s_and_b32 s37, s37, 7
    s_lshl_b32 s37, s37, 12
    s_add_u32 s45, s47, s37
    v_add_u32 v12, s45, v12
    v_mov_b32 v16, 0x7fff
    s_movk_i32 s51, 1024
    v_mov_b32 v7, 8
L_ld2:
    s_waitcnt vmcnt(19)
    global_load_lds_dwordx4 v12, s[6:7] nt
    s_add_u32 m0, m0, s50
    v_add_u32 v12, s51, v12
    s_waitcnt vmcnt(19)
    global_load_lds_dwordx4 v12, s[6:7] nt
    s_add_u32 m0, m0, s50
    v_add_u32 v12, s51, v12
    s_waitcnt vmcnt(19)
    global_load_lds_dwordx4 v12, s[6:7] nt
    s_add_u32 m0, m0, s50
    v_add_u32 v12, s51, v12
    s_waitcnt vmcnt(19)
    ds_max_i32 v3, v7
    global_load_lds_dwordx4 v12, s[6:7] nt
    s_add_u32 m0, m0, s50
    v_add_u32 v12, s51, v12
    v_bfi_b32 v12, v16, v12, s47
    v_add_u32 v7, 4, v7
    s_cmpk_lt_u32 m0, 62016
    s_cbranch_scc1 L_ld2
    v_lshlrev_b32 v6, 1, v8
    v_xor_b32 v6, v9, v6
    v_lshlrev_b32 v6, 4, v6
    v_lshl_add_u32 v13, v8, 8, v6
    v_add_u32 v13, s45, v13
    v_mov_b32 v7, 40
L_ld3:
    s_waitcnt vmcnt(19)
    global_load_lds_dwordx4 v13, s[8:9] nt
    s_add_u32 m0, m0, s50
    v_add_u32 v13, s51, v13
    s_waitcnt vmcnt(19)
    global_load_lds_dwordx4 v13, s[8:9] nt
    s_add_u32 m0, m0, s50
    v_add_u32 v13, s51, v13
    s_waitcnt vmcnt(19)
    global_load_lds_dwordx4 v13, s[8:9] nt
    s_add_u32 m0, m0, s50
    v_add_u32 v13, s51, v13
    s_waitcnt vmcnt(19)
    ds_max_i32 v3, v7
    global_load_lds_dwordx4 v13, s[8:9] nt
    s_add_u32 m0, m0, s50
    v_add_u32 v13, s51, v13
    v_bfi_b32 v13, v16, v13, s47
    v_add_u32 v7, 4, v7
    s_cmp_lt_u32 m0, 96832
    s_cbranch_scc1 L_ld3
    v_lshl_add_u32 v15, v4, 10, v5
    s_lshl_b32 s37, s36, 17
    s_add_u32 s37, s37, s39
    v_add_u32 v14, s37, v15
    s_movk_i32 s51, 8192
    v_mov_b32 v7, 72
L_ld4:
    s_waitcnt vmcnt(19)
    global_load_lds_dwordx4 v14, s[12:13] nt
    s_add_u32 m0, m0, s50
    v_add_u32 v14, s51, v14
    s_waitcnt vmcnt(19)
    global_load_lds_dwordx4 v14, s[12:13] nt
    s_add_u32 m0, m0, s50
    v_add_u32 v14, s51, v14
    s_waitcnt vmcnt(19)
    global_load_lds_dwordx4 v14, s[12:13] nt
    s_add_u32 m0, m0, s50
    v_add_u32 v14, s51, v14
    s_waitcnt vmcnt(19)
    ds_max_i32 v3, v7
    global_load_lds_dwordx4 v14, s[12:13] nt
    s_add_u32 m0, m0, s50
    v_add_u32 v14, s51, v14
    v_add_u32 v7, 4, v7
    s_cmp_lt_u32 m0, 114240
    s_cbranch_scc1 L_ld4
    s_lshl_b32 s37, s46, 16
    s_add_u32 s37, s37, s39
    v_add_u32 v15, s37, v15
    s_mov_b64 exec, s[48:49]
    v_mov_b32 v7, 88
L_ld5:
    s_waitcnt vmcnt(19)
    global_load_lds_dwordx4 v15, s[20:21] nt
    s_add_u32 m0, m0, s50
    v_add_u32 v15, s51, v15
    s_waitcnt vmcnt(19)
    global_load_lds_dwordx4 v15, s[20:21] nt
    s_add_u32 m0, m0, s50
    v_add_u32 v15, s51, v15
    s_waitcnt vmcnt(19)
    global_load_lds_dwordx4 v15, s[20:21] nt
    s_add_u32 m0, m0, s50
    v_add_u32 v15, s51, v15
    s_waitcnt vmcnt(19)
    ds_max_i32 v3, v7
    global_load_lds_dwordx4 v15, s[20:21] nt
    s_add_u32 m0, m0, s50
    v_add_u32 v15, s51, v15
    v_add_u32 v7, 4, v7
    s_cmp_lt_u32 m0, 122944
    s_cbranch_scc1 L_ld5
    s_mov_b64 exec, -1
    v_mov_b32 v7, 104
    s_waitcnt vmcnt(8)
    ds_max_i32 v3, v7
    v_mov_b32 v7, 112
    s_waitcnt vmcnt(0)
    ds_max_i32 v3, v7
    s_branch L_fin
L_comp:
    v_and_b32 v2, 63, v0
    s_lshl_b32 s36, s30, 2
    s_add_u32 s36, s36, s34
    s_mov_b32 s33, 1000000
    v_mov_b32 v3, 122944
    v_lshlrev_b32 v16, 4, v2
    s_sub_u32 s32, s32, 1
    v_and_b32 v20, 15, v2
    v_lshrrev_b32 v21, 4, v2
    v_lshrrev_b32 v22, 2, v20
    v_and_b32 v23, 3, v2
    s_lshl_b32 s38, s30, 13
    s_lshl_b32 s39, s34, 11
    s_add_u32 s38, s38, s39
    s_lshl_b32 s39, s35, 8
    s_lshl_b32 s44, s32, 6
    s_add_u32 s39, s39, s44
    s_add_u32 s38, s38, s39
    s_add_u32 s38, s38, 65536
    v_lshl_add_u32 v12, v20, 2, s38
    s_lshl_b32 s38, s36, 11
    s_add_u32 s38, s38, s39
    s_add_u32 s38, s38, 131072
    v_lshl_add_u32 v13, v20, 2, s38
    s_lshl_b32 s38, s30, 16
    s_lshl_b32 s39, s31, 9
    s_add_u32 s38, s38, s39
    s_lshl_b32 s45, s32, 7
    s_add_u32 s38, s38, s45
    s_add_u32 s38, s38, 262144
    v_lshlrev_b32 v46, 14, v21
    v_lshl_add_u32 v46, v20, 3, v46
    v_add_u32 v46, s38, v46
    s_waitcnt lgkmcnt(0)
    global_load_dword v125, v12, s[28:29] sc1
    global_load_dword v125, v13, s[28:29] sc1
    s_add_u32 s26, s28, 1048576
    s_addc_u32 s27, s29, 0
    s_lshl_b32 s38, s32, 1
    v_lshrrev_b32 v7, 1, v23
    v_add_u32 v4, s38, v7
    v_and_b32 v5, 2, v22
    v_xor_b32 v4, v4, v5
    v_lshlrev_b32 v4, 4, v4
    v_and_b32 v14, 1, v23
    v_lshl_add_u32 v5, v14, 3, v4
    v_lshl_add_u32 v5, v22, 7, v5
    v_mul_u32_u24 v6, 1088, v21
    v_add_u32 v24, v5, v6
    v_add_u32 v25, 96832, v24
    s_mul_i32 s38, s32, 8704
    s_add_u32 s38, s38, 27200
    v_xor_b32 v4, v21, v23
    v_lshlrev_b32 v4, 4, v4
    v_lshl_add_u32 v4, v23, 8, v4
    v_mul_u32_u24 v5, 1088, v22
    v_add3_u32 v26, v4, v5, s38
    s_lshl_b32 s38, s32, 2
    v_add_u32 v4, s38, v7
    v_lshlrev_b32 v5, 1, v22
    v_xor_b32 v4, v4, v5
    v_lshlrev_b32 v4, 4, v4
    v_lshl_add_u32 v4, v14, 3, v4
    v_lshl_add_u32 v4, v22, 8, v4
    v_xor_b32 v5, 32, v4
    v_lshlrev_b32 v6, 1, v6
    v_add_u32 v6, 62016, v6
    v_add_u32 v27, v4, v6
    v_add_u32 v28, v5, v6
    v_add_u32 v44, s38, v3
    v_mov_b32 v19, 0xff
    v_mov_b32 v18, 0x3b000000
    v_mov_b32 v112, v16
    v_add_u32 v16, 123264, v16
    v_lshlrev_b32 v15, 4, v21
    s_lshl_b32 s38, s34, 8
    s_add_u32 s38, s38, 123264
    v_add_u32 v17, s38, v15
    s_barrier
    ds_read_b128 v[8:11], v112
    s_waitcnt lgkmcnt(0)
    v_lshlrev_b32 v32, 16, v8
    v_and_b32 v33, 0xffff0000, v8
    v_lshlrev_b32 v34, 16, v9
    v_and_b32 v35, 0xffff0000, v9
    v_lshlrev_b32 v36, 16, v10
    v_and_b32 v37, 0xffff0000, v10
    v_lshlrev_b32 v38, 16, v11
    v_and_b32 v39, 0xffff0000, v11
    s_mov_b32 s55, 0
L_ln:
    v_pk_mul_f32 v[40:41], v[32:33], v[32:33]
    v_pk_add_f32 v[4:5], v[32:33], v[34:35]
    v_pk_fma_f32 v[40:41], v[34:35], v[34:35], v[40:41]
    v_pk_add_f32 v[6:7], v[36:37], v[38:39]
    v_pk_fma_f32 v[40:41], v[36:37], v[36:37], v[40:41]
    v_pk_add_f32 v[4:5], v[4:5], v[6:7]
    v_pk_fma_f32 v[40:41], v[38:39], v[38:39], v[40:41]
    v_add_f32 v4, v4, v5
    v_add_f32 v5, v40, v41
    s_nop 0
    v_add_f32_dpp v4, v4, v4 row_shr:1 row_mask:0xf bank_mask:0xf bound_ctrl:1
    v_add_f32_dpp v5, v5, v5 row_shr:1 row_mask:0xf bank_mask:0xf bound_ctrl:1
    s_nop 0
    v_add_f32_dpp v4, v4, v4 row_shr:2 row_mask:0xf bank_mask:0xf bound_ctrl:1
    v_add_f32_dpp v5, v5, v5 row_shr:2 row_mask:0xf bank_mask:0xf bound_ctrl:1
    s_nop 0
    v_add_f32_dpp v4, v4, v4 row_shr:4 row_mask:0xf bank_mask:0xf bound_ctrl:1
    v_add_f32_dpp v5, v5, v5 row_shr:4 row_mask:0xf bank_mask:0xf bound_ctrl:1
    s_nop 0
    v_add_f32_dpp v4, v4, v4 row_shr:8 row_mask:0xf bank_mask:0xf bound_ctrl:1
    v_add_f32_dpp v5, v5, v5 row_shr:8 row_mask:0xf bank_mask:0xf bound_ctrl:1
    s_nop 0
    v_add_f32_dpp v4, v4, v4 row_bcast:15 row_mask:0xa bank_mask:0xf
    v_add_f32_dpp v5, v5, v5 row_bcast:15 row_mask:0xa bank_mask:0xf
    s_nop 0
    v_add_f32_dpp v4, v4, v4 row_bcast:31 row_mask:0xc bank_mask:0xf
    v_add_f32_dpp v5, v5, v5 row_bcast:31 row_mask:0xc bank_mask:0xf
    s_nop 0
    v_readlane_b32 s38, v4, 63
    v_readlane_b32 s39, v5, 63
    s_nop 0
    v_mul_f32 v4, s38, v18
    v_mul_f32 v5, s39, v18
    v_fma_f32 v5, -v4, v4, v5
    v_max_f32 v5, 0, v5
    v_cvt_pk_bf16_f32 v4, v4, v5
    v_and_b32 v5, 0xffff0000, v4
    v_lshlrev_b32 v4, 16, v4
    v_add_f32 v5, 0x3727c5ac, v5
    v_cvt_pk_bf16_f32 v5, v5, v5
    v_and_b32 v5, 0xffff0000, v5
    v_sqrt_f32 v6, v5
    v_pk_add_f32 v[32:33], v[32:33], v[4:5] op_sel_hi:[1,0] neg_lo:[0,1] neg_hi:[0,1]
    v_pk_add_f32 v[34:35], v[34:35], v[4:5] op_sel_hi:[1,0] neg_lo:[0,1] neg_hi:[0,1]
    v_pk_add_f32 v[36:37], v[36:37], v[4:5] op_sel_hi:[1,0] neg_lo:[0,1] neg_hi:[0,1]
    v_pk_add_f32 v[38:39], v[38:39], v[4:5] op_sel_hi:[1,0] neg_lo:[0,1] neg_hi:[0,1]
    v_cvt_pk_bf16_f32 v6, v6, v6
    v_and_b32 v6, 0xffff0000, v6
    v_rcp_f32 v6, v6
    v_cvt_pk_bf16_f32 v40, v32, v33
    v_cvt_pk_bf16_f32 v41, v34, v35
    v_cvt_pk_bf16_f32 v42, v36, v37
    v_cvt_pk_bf16_f32 v43, v38, v39
    v_lshlrev_b32 v32, 16, v40
    v_and_b32 v33, 0xffff0000, v40
    v_lshlrev_b32 v34, 16, v41
    v_and_b32 v35, 0xffff0000, v41
    v_lshlrev_b32 v36, 16, v42
    v_and_b32 v37, 0xffff0000, v42
    v_lshlrev_b32 v38, 16, v43
    v_and_b32 v39, 0xffff0000, v43
    v_pk_mul_f32 v[32:33], v[32:33], v[6:7] op_sel_hi:[1,0]
    v_pk_mul_f32 v[34:35], v[34:35], v[6:7] op_sel_hi:[1,0]
    v_pk_mul_f32 v[36:37], v[36:37], v[6:7] op_sel_hi:[1,0]
    v_pk_mul_f32 v[38:39], v[38:39], v[6:7] op_sel_hi:[1,0]
    v_cvt_pk_bf16_f32 v40, v32, v33
    v_cvt_pk_bf16_f32 v41, v34, v35
    v_cvt_pk_bf16_f32 v42, v36, v37
    v_cvt_pk_bf16_f32 v43, v38, v39
    ds_write_b128 v16, v[40:43]
    s_cmp_lg_u32 s55, 0
    s_cbranch_scc1 L_ln2
    ds_read_b128 v[48:51], v17 offset:0
    ds_read_b128 v[52:55], v17 offset:64
    ds_read_b128 v[56:59], v17 offset:128
    ds_read_b128 v[60:63], v17 offset:192
    v_lshlrev_b32 v32, 16, v40
    v_and_b32 v33, 0xffff0000, v40
    v_lshlrev_b32 v34, 16, v41
    v_and_b32 v35, 0xffff0000, v41
    v_lshlrev_b32 v36, 16, v42
    v_and_b32 v37, 0xffff0000, v42
    v_lshlrev_b32 v38, 16, v43
    v_and_b32 v39, 0xffff0000, v43
    s_lshl_b32 s38, s35, 7
    s_add_u32 s38, s38, 124288
    v_add_u32 v17, s38, v15
    v_add_u32 v16, 1024, v16
    s_lshl_b32 s38, s30, 13
    s_lshl_b32 s39, s32, 9
    s_add_u32 s38, s38, s39
    s_add_u32 s38, s38, 65536
    v_lshl_add_u32 v8, v2, 3, s38
    v_add_u32 v9, 4096, v8
    s_mul_i32 s39, s32, 288
    s_add_u32 s39, s39, 125312
    v_lshl_add_u32 v10, v2, 2, s39
    v_mul_u32_u24 v11, 288, v23
    v_add_u32 v11, v11, v15
    v_add_u32 v11, 125312, v11
    s_add_u32 s38, s45, 126464
    v_mul_u32_u24 v47, 576, v23
    v_add3_u32 v47, v47, v15, s38
    v_mul_u32_u24 v115, 576, v22
    v_lshl_add_u32 v115, v23, 7, v115
    v_lshl_add_u32 v115, v21, 5, v115
    v_add_u32 v115, 126464, v115
    s_lshl_b32 s38, s36, 14
    s_add_u32 s38, s38, s45
    s_add_u32 s38, s38, 262144
    v_lshrrev_b32 v6, 3, v2
    v_and_b32 v5, 7, v2
    v_lshlrev_b32 v116, 11, v6
    v_lshl_add_u32 v116, v5, 4, v116
    v_add_u32 v116, s38, v116
    s_add_u32 s38, s44, 128768
    v_mul_u32_u24 v117, 288, v6
    v_lshl_add_u32 v117, v5, 2, v117
    v_add_u32 v117, s38, v117
    v_mov_b32 v118, 0x0c0c0400
    v_mov_b32 v6, 0x04000c0c
    v_cmp_eq_u32 vcc, 1, v14
    v_mul_u32_u24 v119, 288, v5
    v_add_u32 v119, v119, v15
    v_cndmask_b32 v118, v118, v6, vcc
    v_add_u32 v119, 128768, v119
    v_add_u32 v120, 131072, v15
    s_lshl_b32 s38, s35, 15
    s_lshr_b32 s39, s36, 4
    s_lshl_b32 s39, s39, 14
    s_add_u32 s38, s38, s39
    s_and_b32 s39, s36, 15
    s_lshl_b32 s39, s39, 9
    s_add_u32 s38, s38, s39
    s_add_u32 s38, s38, s45
    s_add_u32 s38, s38, 786432
    s_add_u32 s50, s28, 8192
    s_addc_u32 s51, s29, 0
    v_lshl_add_u32 v121, v20, 3, s38
    s_lshl_b32 s52, s32, 3
    s_add_u32 s52, s52, 32
L_wt6:
    ds_read_b64 v[4:5], v3 offset:304
    s_sub_u32 s33, s33, 1
    s_cbranch_scc1 L_fin
    s_waitcnt lgkmcnt(0)
    v_cmp_eq_u32 vcc, 0, v5
    s_cbranch_vccnz L_wt6
    v_lshlrev_b32 v122, 3, v23
    v_lshrrev_b32 v29, v122, v4
    v_lshlrev_b32 v5, 4, v14
    v_lshrrev_b32 v30, v5, v4
    v_lshrrev_b32 v31, 8, v30
    s_getreg_b32 s38, hwreg(HW_REG_XCC_ID, 0, 3)
    v_mul_u32_u24 v5, s38, v14
    v_xor_b32 v113, v30, v5
    v_cmp_eq_u32 vcc, 2, v23
    v_mul_u32_u24 v5, 7, v14
    v_mov_b32 v6, s38
    v_xor_b32 v144, v19, v5
    v_cndmask_b32 v6, 0, v6, vcc
    v_xor_b32 v145, v29, v6
    s_mov_b32 s54, 0
    v_not_b32 v146, v19
    v_and_b32 v5, 1, v22
    v_lshlrev_b32 v5, 3, v5
    v_lshrrev_b32 v148, v5, v30
    v_xor_b32 v6, v113, v30
    v_xor_b32 v148, v148, v6
    v_and_b32 v5, 2, v2
    v_lshlrev_b32 v5, 2, v5
    v_lshrrev_b32 v149, v5, v4
    v_lshrrev_b32 v150, 16, v149
    v_xor_b32 v150, s38, v150
    v_mov_b32 v147, 0x0c0c0400
L_wp7:
    ds_read_b32 v4, v3
    s_sub_u32 s33, s33, 1
    s_cbranch_scc1 L_fin
    s_waitcnt lgkmcnt(0)
    v_cmp_gt_u32 vcc, 16, v4
    s_cbranch_vccnz L_wp7
    ds_read_b64_tr_b16 v[72:73], v24 offset:1088
    ds_read_b64_tr_b16 v[74:75], v24 offset:1600
    ds_read_b64_tr_b16 v[76:77], v24 offset:5440
    ds_read_b64_tr_b16 v[78:79], v24 offset:5952
    ds_read_b64_tr_b16 v[80:81], v24 offset:9792
    ds_read_b64_tr_b16 v[82:83], v24 offset:10304
    ds_read_b64_tr_b16 v[84:85], v24 offset:14144
    ds_read_b64_tr_b16 v[86:87], v24 offset:14656
    s_waitcnt lgkmcnt(6)
    v_mfma_f32_16x16x32_bf16 v[4:7], v[48:51], v[72:75], 0
    s_waitcnt lgkmcnt(4)
    v_mfma_f32_16x16x32_bf16 v[4:7], v[52:55], v[76:79], v[4:7]
    s_waitcnt lgkmcnt(2)
    v_mfma_f32_16x16x32_bf16 v[4:7], v[56:59], v[80:83], v[4:7]
    s_waitcnt lgkmcnt(0)
    v_mfma_f32_16x16x32_bf16 v[4:7], v[60:63], v[84:87], v[4:7]
    s_mov_b64 exec, 0xffff
    s_mov_b32 s55, 1
    s_nop 5
    v_bfi_b32 v123, v19, v145, v4
    global_store_dword v12, v123, s[28:29]
    s_mov_b64 exec, -1
    global_load_dwordx2 v[128:129], v8, s[28:29] sc1
    global_load_dwordx2 v[130:131], v8, s[28:29] offset:2048 sc1
    global_load_dwordx2 v[132:133], v9, s[28:29] sc1
    global_load_dwordx2 v[134:135], v9, s[28:29] offset:2048 sc1
    s_cmp_lg_u32 s30, 7
    s_cbranch_scc1 L_ln
    s_branch L_nomlp1
L_pad3:
    s_branch L_pad4
L_foreign:
    ds_write_b32 v3, v5 offset:300
    s_branch L_own
L_needB:
    s_mov_b64 exec, 0xffff
    global_store_dword v12, v123, s[26:27] sc1
    global_store_dword v13, v124, s[26:27] sc1
    s_mov_b64 exec, -1
    s_mov_b32 s54, 1
    s_branch L_wk
L_ln2:
    ds_read_b128 v[64:67], v17
    ds_read_b128 v[68:71], v17 offset:64
L_wp8:
    ds_read_b32 v4, v3
    s_sub_u32 s33, s33, 1
    s_cbranch_scc1 L_fin
    s_waitcnt lgkmcnt(0)
    v_cmp_gt_u32 vcc, 24, v4
    s_cbranch_vccnz L_wp8
    ds_read_b64_tr_b16 v[72:73], v24 offset:18496
    ds_read_b64_tr_b16 v[74:75], v24 offset:19008
    ds_read_b64_tr_b16 v[76:77], v24 offset:22848
    ds_read_b64_tr_b16 v[78:79], v24 offset:23360
    s_waitcnt lgkmcnt(0)
    v_mfma_f32_16x16x32_bf16 v[4:7], v[64:67], v[72:75], 0
    v_mfma_f32_16x16x32_bf16 v[4:7], v[68:71], v[76:79], v[4:7]
    s_mov_b64 exec, 0xffff
    s_nop 6
    v_bfi_b32 v124, v19, v29, v4
    global_store_dword v13, v124, s[28:29]
    s_mov_b64 exec, -1
L_nomlp1:
    v_add_u32 v112, 18496, v24
    global_load_dwordx2 v[136:137], v8, s[28:29] sc1
    global_load_dwordx2 v[138:139], v8, s[28:29] offset:2048 sc1
    global_load_dwordx2 v[140:141], v9, s[28:29] sc1
    global_load_dwordx2 v[142:143], v9, s[28:29] offset:2048 sc1
    ds_read_b32 v4, v3
    s_mov_b32 s47, 21
    s_mov_b32 s55, 0
    s_waitcnt lgkmcnt(0)
    v_readfirstlane_b32 s53, v4
    s_add_u32 s53, s53, 12
    s_min_u32 s53, s53, 112
L_wp9:
    ds_read_b32 v4, v3
    s_sub_u32 s33, s33, 1
    s_cbranch_scc1 L_fin
    s_waitcnt lgkmcnt(0)
    v_cmp_gt_u32 vcc, s53, v4
    s_cbranch_vccnz L_wp9
L_gq:
    global_load_dwordx2 v[104:105], v8, s[28:29] sc1
    global_load_dwordx2 v[106:107], v8, s[28:29] offset:2048 sc1
    global_load_dwordx2 v[108:109], v9, s[28:29] sc1
    global_load_dwordx2 v[110:111], v9, s[28:29] offset:2048 sc1
    s_sub_u32 s33, s33, 1
    s_cbranch_scc1 L_fin
    s_waitcnt vmcnt(8)
    v_xor_b32 v7, v128, v113
    v_xor_b32 v4, v129, v31
    v_bitop3_b32 v7, v7, v130, v113 bitop3:0xf6
    v_bitop3_b32 v4, v4, v131, v31 bitop3:0xf6
    v_bitop3_b32 v7, v7, v132, v113 bitop3:0xf6
    v_bitop3_b32 v4, v4, v133, v31 bitop3:0xf6
    v_bitop3_b32 v7, v7, v134, v113 bitop3:0xf6
    v_bitop3_b32 v4, v4, v135, v31 bitop3:0xf6
    v_and_b32 v6, v144, v7
    v_and_or_b32 v4, v4, v19, v6
    v_cmp_ne_u32 vcc, 0, v4
    v_and_b32 v128, v146, v128
    v_and_b32 v129, v146, v129
    v_and_b32 v130, v146, v130
    v_and_b32 v131, v146, v131
    v_and_b32 v132, v146, v132
    v_and_b32 v133, v146, v133
    v_and_b32 v134, v146, v134
    v_and_b32 v135, v146, v135
    v_pk_add_f32 v[40:41], v[128:129], v[130:131]
    v_pk_add_f32 v[42:43], v[132:133], v[134:135]
    s_cbranch_vccz L_gqok
    s_sub_u32 s47, s47, 1
    s_cbranch_scc0 L_gq2
    s_mov_b32 s55, 1048576
    v_mov_b32 v5, 1
    ds_write_b32 v3, v5 offset:300
    s_mov_b64 exec, 0xffff
    global_store_dword v12, v123, s[26:27] sc1
    global_store_dword v13, v124, s[26:27] sc1
    s_mov_b64 exec, -1
    s_mov_b32 s54, 1
L_gq2:
    v_xor_b32 v8, s55, v8
    v_xor_b32 v9, s55, v9
    global_load_dwordx2 v[128:129], v8, s[28:29] sc1
    global_load_dwordx2 v[130:131], v8, s[28:29] offset:2048 sc1
    global_load_dwordx2 v[132:133], v9, s[28:29] sc1
    global_load_dwordx2 v[134:135], v9, s[28:29] offset:2048 sc1
    s_waitcnt vmcnt(8)
    v_xor_b32 v7, v136, v113
    v_xor_b32 v4, v137, v31
    v_bitop3_b32 v7, v7, v138, v113 bitop3:0xf6
    v_bitop3_b32 v4, v4, v139, v31 bitop3:0xf6
    v_bitop3_b32 v7, v7, v140, v113 bitop3:0xf6
    v_bitop3_b32 v4, v4, v141, v31 bitop3:0xf6
    v_bitop3_b32 v7, v7, v142, v113 bitop3:0xf6
    v_bitop3_b32 v4, v4, v143, v31 bitop3:0xf6
    v_and_b32 v6, v144, v7
    v_and_or_b32 v4, v4, v19, v6
    v_cmp_ne_u32 vcc, 0, v4
    v_and_b32 v136, v146, v136
    v_and_b32 v137, v146, v137
    v_and_b32 v138, v146, v138
    v_and_b32 v139, v146, v139
    v_and_b32 v140, v146, v140
    v_and_b32 v141, v146, v141
    v_and_b32 v142, v146, v142
    v_and_b32 v143, v146, v143
    v_pk_add_f32 v[40:41], v[136:137], v[138:139]
    v_pk_add_f32 v[42:43], v[140:141], v[142:143]
    s_cbranch_vccz L_gqok
    global_load_dwordx2 v[136:137], v8, s[28:29] sc1
    global_load_dwordx2 v[138:139], v8, s[28:29] offset:2048 sc1
    global_load_dwordx2 v[140:141], v9, s[28:29] sc1
    global_load_dwordx2 v[142:143], v9, s[28:29] offset:2048 sc1
    s_waitcnt vmcnt(8)
    v_xor_b32 v7, v104, v113
    v_xor_b32 v4, v105, v31
    v_bitop3_b32 v7, v7, v106, v113 bitop3:0xf6
    v_bitop3_b32 v4, v4, v107, v31 bitop3:0xf6
    v_bitop3_b32 v7, v7, v108, v113 bitop3:0xf6
    v_bitop3_b32 v4, v4, v109, v31 bitop3:0xf6
    v_bitop3_b32 v7, v7, v110, v113 bitop3:0xf6
    v_bitop3_b32 v4, v4, v111, v31 bitop3:0xf6
    v_and_b32 v6, v144, v7
    v_and_or_b32 v4, v4, v19, v6
    v_cmp_ne_u32 vcc, 0, v4
    v_and_b32 v104, v146, v104
    v_and_b32 v105, v146, v105
    v_and_b32 v106, v146, v106
    v_and_b32 v107, v146, v107
    v_and_b32 v108, v146, v108
    v_and_b32 v109, v146, v109
    v_and_b32 v110, v146, v110
    v_and_b32 v111, v146, v111
    v_pk_add_f32 v[40:41], v[104:105], v[106:107]
    v_pk_add_f32 v[42:43], v[108:109], v[110:111]
    s_cbranch_vccnz L_gq
L_gqok:
    v_pk_add_f32 v[40:41], v[40:41], v[42:43]
    v_and_b32 v7, 7, v7
    v_mov_b32 v5, 1
    v_cmp_ne_u32 vcc, 0, v7
    v_cvt_pk_bf16_f32 v40, v40, v41
    ds_write_b32 v10, v40
    s_cbranch_vccnz L_foreign
L_own:
    ds_write_b32 v44, v5 offset:256
L_wk:
    ds_read_b32 v40, v3
    ds_read_b128 v[4:7], v3 offset:256
    ds_read_b32 v41, v3 offset:300
    ds_read_b128 v[48:51], v11 offset:0
    ds_read_b128 v[52:55], v11 offset:64
    ds_read_b128 v[56:59], v11 offset:128
    ds_read_b128 v[60:63], v11 offset:192
    s_sub_u32 s33, s33, 1
    s_cbranch_scc1 L_fin
    s_waitcnt lgkmcnt(4)
    v_readfirstlane_b32 s38, v41
    v_bitop3_b32 v4, v4, v5, v6 bitop3:0x80
    v_cmp_gt_u32 s[60:61], s52, v40
    v_and_b32 v4, v4, v7
    s_min_u32 s38, s38, 1
    s_cmp_gt_u32 s38, s54
    s_cbranch_scc1 L_needB
    v_cmp_eq_u32 vcc, 0, v4
    s_or_b64 s[60:61], vcc, s[60:61]
    s_cbranch_scc1 L_wk
    ds_read_b128 v[72:75], v26 offset:0
    ds_read_b128 v[88:91], v26 offset:4352
    ds_read_b128 v[76:79], v26 offset:64
    ds_read_b128 v[92:95], v26 offset:4416
    ds_read_b128 v[80:83], v26 offset:128
    ds_read_b128 v[96:99], v26 offset:4480
    ds_read_b128 v[84:87], v26 offset:192
    ds_read_b128 v[100:103], v26 offset:4544
    s_waitcnt lgkmcnt(7)
    v_mfma_f32_16x16x32_bf16 v[32:35], v[72:75], v[48:51], 0
    s_waitcnt lgkmcnt(6)
    v_mfma_f32_16x16x32_bf16 v[36:39], v[88:91], v[48:51], 0
    s_waitcnt lgkmcnt(5)
    v_mfma_f32_16x16x32_bf16 v[32:35], v[76:79], v[52:55], v[32:35]
    s_waitcnt lgkmcnt(4)
    v_mfma_f32_16x16x32_bf16 v[36:39], v[92:95], v[52:55], v[36:39]
    s_waitcnt lgkmcnt(3)
    v_mfma_f32_16x16x32_bf16 v[32:35], v[80:83], v[56:59], v[32:35]
    s_waitcnt lgkmcnt(2)
    v_mfma_f32_16x16x32_bf16 v[36:39], v[96:99], v[56:59], v[36:39]
    s_waitcnt lgkmcnt(1)
    v_mfma_f32_16x16x32_bf16 v[32:35], v[84:87], v[60:63], v[32:35]
    s_waitcnt lgkmcnt(0)
    v_mfma_f32_16x16x32_bf16 v[36:39], v[100:103], v[60:63], v[36:39]
    s_mov_b32 exec_lo, 0x000f000f
    s_mov_b32 exec_hi, 0x000f000f
    v_mov_b32 v5, 1
    s_mov_b32 s46, 1040356334
    s_nop 3
    ds_write_b128 v47, v[32:35]
    ds_write_b128 v47, v[36:39] offset:64
    ds_write_b32 v44, v5 offset:272
    s_mov_b64 exec, -1
    v_mov_b32 v64, 0x3f803f80
    v_mov_b32 v65, v64
    v_mov_b32 v66, v64
    v_mov_b32 v67, v64
    global_load_dword v114, v46, s[28:29] sc1
    global_load_dword v114, v121, s[28:29] sc1
    global_load_dword v114, v121, s[50:51] sc1
    s_branch L_po4
L_pad4:
    s_branch L_pad5
L_po4:
L_ws:
    ds_read_b128 v[4:7], v3 offset:272
    ds_read_b32 v40, v3
    ds_read_b128 v[32:35], v115
    ds_read_b128 v[36:39], v115 offset:16
    s_sub_u32 s33, s33, 1
    s_cbranch_scc1 L_fin
    s_waitcnt lgkmcnt(2)
    v_bitop3_b32 v4, v4, v5, v6 bitop3:0x80
    v_readfirstlane_b32 s53, v40
    v_and_b32 v4, v4, v7
    v_cmp_eq_u32 vcc, 0, v4
    s_cbranch_vccnz L_ws
    s_waitcnt lgkmcnt(0)
    v_max3_f32 v4, v32, v33, v34
    v_max3_f32 v5, v35, v36, v37
    v_max3_f32 v4, v4, v38, v39
    v_max_f32 v4, v4, v5
    ds_read_b64_tr_b16 v[72:73], v27 offset:0
    ds_read_b64_tr_b16 v[74:75], v27 offset:1088
    v_max_f32_dpp v4, v4, v4 quad_perm:[1,0,3,2] row_mask:0xf bank_mask:0xf
    ds_read_b64_tr_b16 v[76:77], v28 offset:0
    ds_read_b64_tr_b16 v[78:79], v28 offset:1088
    v_max_f32_dpp v4, v4, v4 quad_perm:[2,3,0,1] row_mask:0xf bank_mask:0xf
    v_mov_b32 v5, v4
    ds_read_b64_tr_b16 v[80:81], v27 offset:8704
    ds_read_b64_tr_b16 v[82:83], v27 offset:9792
    v_permlane16_swap_b32 v4, v5
    v_max_f32 v4, v4, v5
    v_mov_b32 v5, v4
    ds_read_b64_tr_b16 v[84:85], v28 offset:8704
    ds_read_b64_tr_b16 v[86:87], v28 offset:9792
    v_permlane32_swap_b32 v4, v5
    v_max_f32 v4, v4, v5
    v_mul_f32 v6, s46, v4
    v_fma_f32 v32, v32, s46, -v6
    ds_bpermute_b32 v45, v15, v6
    v_fma_f32 v33, v33, s46, -v6
    v_fma_f32 v34, v34, s46, -v6
    v_fma_f32 v35, v35, s46, -v6
    v_fma_f32 v36, v36, s46, -v6
    v_fma_f32 v37, v37, s46, -v6
    v_fma_f32 v38, v38, s46, -v6
    v_fma_f32 v39, v39, s46, -v6
    v_exp_f32 v32, v32
    ds_read_b64_tr_b16 v[88:89], v27 offset:17408
    v_exp_f32 v33, v33
    ds_read_b64_tr_b16 v[90:91], v27 offset:18496
    v_exp_f32 v34, v34
    ds_read_b64_tr_b16 v[92:93], v28 offset:17408
    v_exp_f32 v35, v35
    ds_read_b64_tr_b16 v[94:95], v28 offset:18496
    v_exp_f32 v36, v36
    ds_read_b64_tr_b16 v[96:97], v27 offset:26112
    v_exp_f32 v37, v37
    ds_read_b64_tr_b16 v[98:99], v27 offset:27200
    v_exp_f32 v38, v38
    ds_read_b64_tr_b16 v[100:101], v28 offset:26112
    v_exp_f32 v39, v39
    ds_read_b64_tr_b16 v[102:103], v28 offset:27200
    v_cvt_pk_bf16_f32 v40, v32, v33
    v_cvt_pk_bf16_f32 v41, v34, v35
    v_cvt_pk_bf16_f32 v42, v36, v37
    v_cvt_pk_bf16_f32 v43, v38, v39
    v_mov_b32_dpp v48, v40 quad_perm:[0,0,0,0] row_mask:0xf bank_mask:0xf
    v_mov_b32_dpp v49, v41 quad_perm:[0,0,0,0] row_mask:0xf bank_mask:0xf
    v_mfma_f32_16x16x32_bf16 v[68:71], v[40:43], v[64:67], 0
    v_mov_b32_dpp v50, v42 quad_perm:[0,0,0,0] row_mask:0xf bank_mask:0xf
    v_mov_b32_dpp v51, v43 quad_perm:[0,0,0,0] row_mask:0xf bank_mask:0xf
    s_cmpk_ge_u32 s53, 64
    s_cbranch_scc1 L_vs10
L_wv11:
    ds_read_b32 v4, v3
    ds_read_b64_tr_b16 v[72:73], v27 offset:0
    ds_read_b64_tr_b16 v[74:75], v27 offset:1088
    ds_read_b64_tr_b16 v[76:77], v28 offset:0
    ds_read_b64_tr_b16 v[78:79], v28 offset:1088
    s_sub_u32 s33, s33, 1
    s_cbranch_scc1 L_fin
    s_waitcnt lgkmcnt(4)
    v_cmp_gt_u32 vcc, 64, v4
    s_cbranch_vccnz L_wv11
L_vs10:
    s_waitcnt lgkmcnt(0)
    v_mfma_f32_16x16x32_bf16 v[32:35], v[48:51], v[72:75], 0
    v_mfma_f32_16x16x32_bf16 v[36:39], v[48:51], v[76:79], 0
    v_mov_b32_dpp v52, v40 quad_perm:[1,1,1,1] row_mask:0xf bank_mask:0xf
    v_mov_b32_dpp v53, v41 quad_perm:[1,1,1,1] row_mask:0xf bank_mask:0xf
    v_mov_b32_dpp v54, v42 quad_perm:[1,1,1,1] row_mask:0xf bank_mask:0xf
    v_mov_b32_dpp v55, v43 quad_perm:[1,1,1,1] row_mask:0xf bank_mask:0xf
    s_cmpk_ge_u32 s53, 72
    s_cbranch_scc1 L_vs12
L_wv13:
    ds_read_b32 v4, v3
    ds_read_b64_tr_b16 v[80:81], v27 offset:8704
    ds_read_b64_tr_b16 v[82:83], v27 offset:9792
    ds_read_b64_tr_b16 v[84:85], v28 offset:8704
    ds_read_b64_tr_b16 v[86:87], v28 offset:9792
    s_sub_u32 s33, s33, 1
    s_cbranch_scc1 L_fin
    s_waitcnt lgkmcnt(4)
    v_cmp_gt_u32 vcc, 72, v4
    s_cbranch_vccnz L_wv13
L_vs12:
    s_waitcnt lgkmcnt(0)
    v_mfma_f32_16x16x32_bf16 v[32:35], v[52:55], v[80:83], v[32:35]
    v_mfma_f32_16x16x32_bf16 v[36:39], v[52:55], v[84:87], v[36:39]
    v_pk_add_f32 v[68:69], v[68:69], v[70:71]
    v_add_f32 v68, v68, v69
    v_log_f32 v5, v68
    v_rcp_f32 v6, v68
    v_add_f32 v45, v45, v5
    v_lshrrev_b32 v45, v122, v45
    ds_read_b32 v7, v3 offset:288
    v_mov_b32_dpp v56, v40 quad_perm:[2,2,2,2] row_mask:0xf bank_mask:0xf
    v_mov_b32_dpp v57, v41 quad_perm:[2,2,2,2] row_mask:0xf bank_mask:0xf
    v_mov_b32_dpp v58, v42 quad_perm:[2,2,2,2] row_mask:0xf bank_mask:0xf
    v_mov_b32_dpp v59, v43 quad_perm:[2,2,2,2] row_mask:0xf bank_mask:0xf
    s_cmpk_ge_u32 s53, 80
    s_cbranch_scc1 L_vs14
L_wv15:
    ds_read_b32 v4, v3
    ds_read_b64_tr_b16 v[88:89], v27 offset:17408
    ds_read_b64_tr_b16 v[90:91], v27 offset:18496
    ds_read_b64_tr_b16 v[92:93], v28 offset:17408
    ds_read_b64_tr_b16 v[94:95], v28 offset:18496
    s_sub_u32 s33, s33, 1
    s_cbranch_scc1 L_fin
    s_waitcnt lgkmcnt(4)
    v_cmp_gt_u32 vcc, 80, v4
    s_cbranch_vccnz L_wv15
L_vs14:
    s_waitcnt lgkmcnt(0)
    v_mfma_f32_16x16x32_bf16 v[32:35], v[56:59], v[88:91], v[32:35]
    v_mfma_f32_16x16x32_bf16 v[36:39], v[56:59], v[92:95], v[36:39]
    v_mul_u32_u24 v7, v7, v14
    v_xor_b32 v148, v148, v7
    v_mov_b32_dpp v60, v40 quad_perm:[3,3,3,3] row_mask:0xf bank_mask:0xf
    v_mov_b32_dpp v61, v41 quad_perm:[3,3,3,3] row_mask:0xf bank_mask:0xf
    v_mov_b32_dpp v62, v42 quad_perm:[3,3,3,3] row_mask:0xf bank_mask:0xf
    v_mov_b32_dpp v63, v43 quad_perm:[3,3,3,3] row_mask:0xf bank_mask:0xf
    s_cmpk_ge_u32 s53, 88
    s_cbranch_scc1 L_vs16
L_wv17:
    ds_read_b32 v4, v3
    ds_read_b64_tr_b16 v[96:97], v27 offset:26112
    ds_read_b64_tr_b16 v[98:99], v27 offset:27200
    ds_read_b64_tr_b16 v[100:101], v28 offset:26112
    ds_read_b64_tr_b16 v[102:103], v28 offset:27200
    s_sub_u32 s33, s33, 1
    s_cbranch_scc1 L_fin
    s_waitcnt lgkmcnt(4)
    v_cmp_gt_u32 vcc, 88, v4
    s_cbranch_vccnz L_wv17
L_vs16:
    s_waitcnt lgkmcnt(0)
    v_mfma_f32_16x16x32_bf16 v[32:35], v[60:63], v[96:99], v[32:35]
    v_mfma_f32_16x16x32_bf16 v[36:39], v[60:63], v[100:103], v[36:39]
    s_nop 6
    v_mul_f32 v32, v32, v6
    v_bfi_b32 v126, v19, v148, v32
    v_mul_f32 v36, v36, v6
    v_bfi_b32 v127, v19, v45, v36
    global_store_dwordx2 v46, v[126:127], s[28:29]
L_wp18:
    ds_read_b32 v4, v3
    s_sub_u32 s33, s33, 1
    s_cbranch_scc1 L_fin
    s_waitcnt lgkmcnt(0)
    v_cmp_gt_u32 vcc, 104, v4
    s_cbranch_vccnz L_wp18
    global_load_dwordx4 v[48:51], v116, s[28:29] offset:0 sc1
    global_load_dwordx4 v[52:55], v116, s[28:29] offset:512 sc1
    global_load_dwordx4 v[56:59], v116, s[28:29] offset:1024 sc1
    global_load_dwordx4 v[60:63], v116, s[28:29] offset:1536 sc1
    s_mov_b32 s47, 64
    s_mov_b32 s55, 0
    s_branch L_go1
L_pad5:
    s_branch L_pad6
L_go:
    s_sub_u32 s47, s47, 1
    s_cbranch_scc0 L_go2
    s_mov_b32 s55, 1048576
    global_store_dwordx2 v46, v[126:127], s[26:27] sc1
L_go2:
    v_xor_b32 v116, s55, v116
    global_load_dwordx4 v[48:51], v116, s[28:29] offset:0 sc1
    global_load_dwordx4 v[52:55], v116, s[28:29] offset:512 sc1
    global_load_dwordx4 v[56:59], v116, s[28:29] offset:1024 sc1
    global_load_dwordx4 v[60:63], v116, s[28:29] offset:1536 sc1
L_go1:
    s_sub_u32 s33, s33, 1
    s_cbranch_scc1 L_fin
    s_waitcnt vmcnt(0)
    v_xor_b32 v7, v150, v50
    v_xor_b32 v4, v149, v48
    v_bitop3_b32 v7, v7, v54, v150 bitop3:0xf6
    v_bitop3_b32 v4, v4, v52, v149 bitop3:0xf6
    v_bitop3_b32 v7, v7, v58, v150 bitop3:0xf6
    v_bitop3_b32 v4, v4, v56, v149 bitop3:0xf6
    v_bitop3_b32 v7, v7, v62, v150 bitop3:0xf6
    v_bitop3_b32 v4, v4, v60, v149 bitop3:0xf6
    v_and_b32 v6, 0xf0, v7
    v_and_or_b32 v4, v4, v19, v6
    v_cmp_ne_u32 vcc, 0, v4
    v_perm_b32 v40, v51, v49, v118
    v_perm_b32 v41, v55, v53, v118
    s_cbranch_vccnz L_go
    v_perm_b32 v42, v59, v57, v118
    v_perm_b32 v43, v63, v61, v118
    v_or_b32_dpp v40, v40, v40 quad_perm:[1,0,3,2] row_mask:0xf bank_mask:0xf
    v_or_b32_dpp v41, v41, v41 quad_perm:[1,0,3,2] row_mask:0xf bank_mask:0xf
    v_or_b32_dpp v42, v42, v42 quad_perm:[1,0,3,2] row_mask:0xf bank_mask:0xf
    v_or_b32_dpp v43, v43, v43 quad_perm:[1,0,3,2] row_mask:0xf bank_mask:0xf
    v_max_f32 v5, v40, v41
    v_perm_b32 v104, v54, v50, v147
    v_max3_f32 v5, v5, v42, v43
    v_and_b32 v7, 7, v7
    v_cmp_ne_u32 vcc, 0, v7
    v_max_f32_dpp v5, v5, v5 row_ror:8 row_mask:0xf bank_mask:0xf
    v_mov_b32 v6, v5
    v_and_b32 v48, v146, v48
    v_and_b32 v52, v146, v52
    v_permlane16_swap_b32 v5, v6
    v_max_f32 v5, v5, v6
    v_mov_b32 v6, v5
    v_and_b32 v56, v146, v56
    v_and_b32 v60, v146, v60
    v_permlane32_swap_b32 v5, v6
    v_max_f32 v5, v5, v6
    v_sub_f32 v40, v40, v5
    v_sub_f32 v41, v41, v5
    v_perm_b32 v105, v62, v58, v147
    v_exp_f32 v40, v40
    v_sub_f32 v42, v42, v5
    v_exp_f32 v41, v41
    v_sub_f32 v43, v43, v5
    v_exp_f32 v42, v42
    v_and_b32 v50, v146, v50
    v_exp_f32 v43, v43
    v_and_b32 v54, v146, v54
    v_and_b32 v58, v146, v58
    v_and_b32 v62, v146, v62
    v_pk_mul_f32 v[32:33], v[48:49], v[40:41] op_sel_hi:[1,0]
    v_pk_mul_f32 v[34:35], v[50:51], v[40:41] op_sel_hi:[1,0]
    v_pk_fma_f32 v[32:33], v[52:53], v[40:41], v[32:33] op_sel:[0,1,0] op_sel_hi:[1,1,1]
    v_pk_fma_f32 v[34:35], v[54:55], v[40:41], v[34:35] op_sel:[0,1,0] op_sel_hi:[1,1,1]
    v_pk_fma_f32 v[32:33], v[56:57], v[42:43], v[32:33] op_sel_hi:[1,0,1]
    v_pk_fma_f32 v[34:35], v[58:59], v[42:43], v[34:35] op_sel_hi:[1,0,1]
    v_pk_fma_f32 v[32:33], v[60:61], v[42:43], v[32:33] op_sel:[0,1,0] op_sel_hi:[1,1,1]
    v_pk_fma_f32 v[34:35], v[62:63], v[42:43], v[34:35] op_sel:[0,1,0] op_sel_hi:[1,1,1]
    v_cvt_pk_bf16_f32 v4, v32, v34
    v_cvt_pk_bf16_f32 v5, v33, v35
    ds_write2_b32 v117, v4, v5 offset0:0 offset1:8
    v_pk_add_f32 v[40:41], v[40:41], v[42:43]
    v_add_f32 v40, v40, v41
    s_cbranch_vccz L_coloc
    global_store_dwordx2 v46, v[126:127], s[26:27] sc1
L_coloc:
    s_waitcnt lgkmcnt(0)
    s_barrier
    ds_read_b128 v[128:131], v119 offset:0
    ds_read_b64_tr_b16 v[72:73], v25 offset:0
    ds_read_b64_tr_b16 v[74:75], v25 offset:512
    v_add_f32_dpp v40, v40, v40 row_ror:8 row_mask:0xf bank_mask:0xf
    v_mov_b32 v41, v40
    ds_read_b128 v[132:135], v119 offset:64
    ds_read_b64_tr_b16 v[76:77], v25 offset:4352
    ds_read_b64_tr_b16 v[78:79], v25 offset:4864
    v_permlane16_swap_b32 v40, v41
    v_add_f32 v40, v40, v41
    v_mov_b32 v41, v40
    ds_read_b128 v[136:139], v119 offset:128
    ds_read_b64_tr_b16 v[80:81], v25 offset:8704
    ds_read_b64_tr_b16 v[82:83], v25 offset:9216
    v_permlane32_swap_b32 v40, v41
    v_add_f32 v40, v40, v41
    v_rcp_f32 v40, v40
    ds_read_b128 v[140:143], v119 offset:192
    ds_read_b64_tr_b16 v[84:85], v25 offset:13056
    ds_read_b64_tr_b16 v[86:87], v25 offset:13568
    s_waitcnt lgkmcnt(9)
    v_mfma_f32_16x16x32_bf16 v[32:35], v[128:131], v[72:75], 0
    ds_read_b128 v[64:67], v120 offset:0
    ds_read_b64_tr_b16 v[88:89], v25 offset:17408
    ds_read_b64_tr_b16 v[90:91], v25 offset:17920
    ds_read_b128 v[68:71], v120 offset:64
    ds_read_b64_tr_b16 v[92:93], v25 offset:21760
    ds_read_b64_tr_b16 v[94:95], v25 offset:22272
    s_waitcnt lgkmcnt(12)
    v_mfma_f32_16x16x32_bf16 v[32:35], v[132:135], v[76:79], v[32:35]
    s_waitcnt lgkmcnt(9)
    v_mfma_f32_16x16x32_bf16 v[32:35], v[136:139], v[80:83], v[32:35]
    s_waitcnt lgkmcnt(6)
    v_mfma_f32_16x16x32_bf16 v[32:35], v[140:143], v[84:87], v[32:35]
    s_waitcnt lgkmcnt(0)
    v_mfma_f32_16x16x32_bf16 v[36:39], v[64:67], v[88:91], 0
    v_mfma_f32_16x16x32_bf16 v[36:39], v[68:71], v[92:95], v[36:39]
    s_nop 4
    v_pk_add_f32 v[32:33], v[32:33], v[34:35]
    v_add_f32 v4, v32, v33
    v_add_f32 v6, v32, v33
    s_cmp_lg_u32 s30, 7
    s_cselect_b32 s38, -1, 0
    v_permlane16_swap_b32 v4, v6
    v_add_f32 v4, v4, v6
    s_mov_b64 exec, 0xffff
    v_mul_f32 v4, v4, v40
    v_and_b32 v5, s38, v36
    v_bfi_b32 v4, v19, v30, v4
    v_bfi_b32 v5, v19, v31, v5
    global_store_dwordx2 v121, v[4:5], s[28:29] sc1
    global_store_dwordx2 v121, v[4:5], s[50:51] sc1
    s_mov_b64 exec, -1
    s_cmp_lg_u32 s32, 0
    s_cbranch_scc1 L_fin
    v_and_b32 v4, 8, v150
    v_lshl_or_b32 v4, v4, 8, v4
    v_xor_b32 v104, v4, v104
    v_xor_b32 v105, v4, v105
    v_and_b32 v4, 8, v104
    v_and_b32 v5, 0x800, v104
    v_and_b32 v6, 8, v105
    v_and_b32 v7, 0x800, v105
    v_cmp_ne_u32 s[60:61], 0, v4
    v_cmp_ne_u32 s[52:53], 0, v5
    v_cmp_ne_u32 s[48:49], 0, v6
    v_cmp_ne_u32 vcc, 0, v7
    s_bcnt1_i32_b64 s38, s[60:61]
    s_bcnt1_i32_b64 s39, s[52:53]
    s_add_u32 s38, s38, s39
    s_bcnt1_i32_b64 s39, s[48:49]
    s_add_u32 s38, s38, s39
    s_bcnt1_i32_b64 s39, vcc
    s_add_u32 s38, s38, s39
    s_cmpk_gt_u32 s38, 128
    s_cselect_b32 s38, 8193, 1
    v_mov_b32 v4, s38
    ds_write_b32 v3, v4 offset:292
    s_branch L_fin
L_aux:
    v_and_b32 v2, 63, v0
    s_lshl_b32 s36, s30, 2
    s_add_u32 s36, s36, s34
    s_mov_b32 s33, 1000000
    v_mov_b32 v3, 122944
    v_mov_b32 v4, 0
    v_lshl_add_u32 v5, v2, 2, v3
    ds_write_b32 v5, v4
    ds_write_b32 v5, v4 offset:64
    s_cmp_ge_u32 s30, 7
    s_cselect_b32 s38, 4, 0
    s_sub_u32 s38, s36, s38
    s_lshl_b32 s38, s38, 7
    v_lshl_add_u32 v6, v2, 1, s38
    s_lshl_b32 s48, s34, 3
    s_add_u32 s48, s48, s30
    s_lshl_b32 s48, s48, 2
    s_and_b32 s38, s31, 3
    s_add_u32 s48, s48, s38
    s_lshl_b32 s38, s48, 3
    v_lshrrev_b32 v20, 5, v2
    v_and_b32 v21, 1, v2
    v_lshlrev_b32 v4, 2, v20
    v_lshl_add_u32 v4, v21, 1, v4
    v_add_u32 v12, s38, v4
    s_waitcnt lgkmcnt(0)
    s_load_dword s37, s[28:29], 0
    s_cmp_eq_u32 s30, 7
    s_cbranch_scc1 L_aux0
    global_load_ushort v8, v6, s[18:19]
L_aux0:
    global_load_ushort v9, v12, s[4:5]
    global_load_ushort v10, v12, s[22:23]
    s_barrier
    v_mov_b32 v5, 1
    v_mov_b32 v19, 0xff
    s_lshr_b32 s38, s48, 4
    s_lshl_b32 s38, s38, 15
    s_and_b32 s39, s48, 15
    s_lshl_b32 s39, s39, 5
    s_add_u32 s38, s38, s39
    s_add_u32 s38, s38, 786432
    v_and_b32 v22, 15, v2
    v_bfe_u32 v23, v2, 4, 1
    v_lshlrev_b32 v17, 9, v22
    v_lshl_add_u32 v17, v23, 14, v17
    v_lshl_add_u32 v17, v20, 4, v17
    v_add_u32 v17, s38, v17
    v_cmp_eq_u32 s[46:47], 1, v21
    s_waitcnt lgkmcnt(0)
    s_add_u32 s37, s37, 1
    s_mul_i32 s40, s37, 0x9E3779B1
    v_mov_b32 v4, s40
    ds_write_b64 v3, v[4:5] offset:304
    s_lshr_b32 s41, s40, 8
    s_lshr_b32 s42, s40, 16
    s_lshr_b32 s43, s40, 24
    v_and_b32 v4, 3, v2
    v_lshlrev_b32 v4, 3, v4
    v_lshrrev_b32 v29, v4, s40
    s_lshr_b32 s38, s2, 4
    s_lshl_b32 s38, s38, 14
    s_and_b32 s39, s2, 15
    s_lshl_b32 s39, s39, 9
    s_add_u32 s38, s38, s39
    s_add_u32 s38, s38, 1835008
    s_add_u32 s52, s28, s38
    s_addc_u32 s53, s29, 0
    s_branch L_pad3
L_auxw:
    s_lshl_b32 s38, s36, 11
    s_add_u32 s38, s38, 131072
    v_lshl_add_u32 v16, v2, 2, s38
    s_mov_b32 s49, 64
    s_mov_b32 s55, 0
L_wp19:
    ds_read_b32 v4, v3
    s_sub_u32 s33, s33, 1
    s_cbranch_scc1 L_fin
    s_waitcnt lgkmcnt(0)
    v_cmp_gt_u32 vcc, 56, v4
    s_cbranch_vccnz L_wp19
    s_cmp_eq_u32 s30, 7
    s_cbranch_scc1 L_noh
    global_load_dword v32, v16, s[28:29] offset:0 sc1
    global_load_dword v33, v16, s[28:29] offset:256 sc1
    global_load_dword v34, v16, s[28:29] offset:512 sc1
    global_load_dword v35, v16, s[28:29] offset:768 sc1
    global_load_dword v36, v16, s[28:29] offset:1024 sc1
    global_load_dword v37, v16, s[28:29] offset:1280 sc1
    global_load_dword v38, v16, s[28:29] offset:1536 sc1
    global_load_dword v39, v16, s[28:29] offset:1792 sc1
L_noh:
    s_mov_b32 s44, s40
    s_mov_b32 s45, s40
    s_mov_b64 s[72:73], s[44:45]
    s_mov_b64 s[74:75], s[44:45]
    s_mov_b64 s[76:77], s[44:45]
    s_mov_b64 s[78:79], s[44:45]
    s_movk_i32 s39, 200
    s_load_dword s72, s[52:53], 0
    s_load_dword s76, s[52:53], 8192
    s_load_dword s77, s[52:53], 8320
    s_load_dword s73, s[52:53], 128
    s_load_dword s78, s[52:53], 8448
    s_load_dword s74, s[52:53], 256
    s_load_dword s75, s[52:53], 384
    s_load_dword s79, s[52:53], 8576
L_race:
    s_cmp_lg_u64 s[72:73], s[44:45]
    s_cbranch_scc1 L_near0
    s_cmp_lg_u64 s[76:77], s[44:45]
    s_cbranch_scc1 L_near1
    s_cmp_lg_u64 s[74:75], s[44:45]
    s_cbranch_scc1 L_near0
    s_sub_u32 s39, s39, 1
    s_cbranch_scc1 L_near0
    s_cmp_lg_u64 s[78:79], s[44:45]
    s_cbranch_scc0 L_race
L_near1:
    v_mov_b32 v4, 8
    ds_write_b32 v3, v4 offset:288
L_near0:
    s_waitcnt lgkmcnt(0)
    s_cmp_eq_u32 s30, 7
    s_cbranch_scc1 L_aux1
    s_branch L_ghc
L_gh:
    s_sub_u32 s49, s49, 1
    s_cselect_b32 s55, 1048576, s55
    v_xor_b32 v16, s55, v16
    global_load_dword v32, v16, s[28:29] offset:0 sc1
    global_load_dword v33, v16, s[28:29] offset:256 sc1
    global_load_dword v34, v16, s[28:29] offset:512 sc1
    global_load_dword v35, v16, s[28:29] offset:768 sc1
    global_load_dword v36, v16, s[28:29] offset:1024 sc1
    global_load_dword v37, v16, s[28:29] offset:1280 sc1
    global_load_dword v38, v16, s[28:29] offset:1536 sc1
    global_load_dword v39, v16, s[28:29] offset:1792 sc1
L_ghc:
    s_sub_u32 s33, s33, 1
    s_cbranch_scc1 L_fin
    s_waitcnt vmcnt(0)
    v_xor_b32 v4, v32, v29
    v_bitop3_b32 v4, v4, v33, v29 bitop3:0xf6
    v_bitop3_b32 v4, v4, v34, v29 bitop3:0xf6
    v_bitop3_b32 v4, v4, v35, v29 bitop3:0xf6
    v_bitop3_b32 v4, v4, v36, v29 bitop3:0xf6
    v_bitop3_b32 v4, v4, v37, v29 bitop3:0xf6
    v_bitop3_b32 v4, v4, v38, v29 bitop3:0xf6
    v_bitop3_b32 v4, v4, v39, v29 bitop3:0xf6
    v_and_b32 v4, v19, v4
    v_cmp_ne_u32 vcc, 0, v4
    s_cbranch_vccnz L_gh
    v_and_b32 v32, 0xffffff00, v32
    v_and_b32 v33, 0xffffff00, v33
    v_and_b32 v34, 0xffffff00, v34
    v_and_b32 v35, 0xffffff00, v35
    v_and_b32 v36, 0xffffff00, v36
    v_and_b32 v37, 0xffffff00, v37
    v_and_b32 v38, 0xffffff00, v38
    v_and_b32 v39, 0xffffff00, v39
    v_pk_add_f32 v[32:33], v[32:33], v[34:35]
    v_pk_add_f32 v[36:37], v[36:37], v[38:39]
    v_pk_add_f32 v[32:33], v[32:33], v[36:37]
    v_add_f32 v32, v32, v33
    v_cvt_pk_bf16_f32 v32, v32, v32
    v_and_b32 v32, 0xffff0000, v32
    v_lshlrev_b32 v8, 16, v8
    v_add_f32 v32, v32, v8
    v_cvt_pk_bf16_f32 v32, v32, v32
    v_and_b32 v32, 0xffff0000, v32
    v_mul_f32 v33, v32, v32
    v_mov_b32 v34, 3222493025
    v_fmac_f32 v34, 3184710632, v33
    v_mul_f32 v33, v34, v32
    v_exp_f32 v33, v33
    v_lshlrev_b32 v5, 1, v2
    v_add_f32 v33, 1.0, v33
    v_rcp_f32 v33, v33
    v_add_u32 v5, 131072, v5
    v_mul_f32 v32, v32, v33
    v_cvt_pk_bf16_f32 v32, v32, v32
    ds_write_b16 v5, v32
    s_branch L_po6
L_pad6:
    s_branch L_auxw
L_po6:
L_aux1:
    s_waitcnt vmcnt(0) lgkmcnt(0)
    v_lshlrev_b32 v9, 16, v9
    v_lshlrev_b32 v10, 16, v10
    s_and_b32 s40, s40, 0xff
    s_and_b32 s41, s41, 0xff
    s_and_b32 s42, s42, 0xff
    s_barrier
    s_bitcmp1_b32 s31, 2
    s_cbranch_scc1 L_fin
L_w120:
    ds_read_b32 v4, v3 offset:292
    s_sub_u32 s33, s33, 1
    s_cbranch_scc1 L_fin
    s_waitcnt lgkmcnt(0)
    v_cmp_eq_u32 vcc, 0, v4
    s_cbranch_vccnz L_w120
    v_add_u32 v17, v17, v4
    v_add_u32 v17, -1, v17
    global_load_dwordx4 v[32:35], v17, s[28:29] sc1
L_gf:
    global_load_dwordx4 v[36:39], v17, s[28:29] sc1
    s_sub_u32 s33, s33, 1
    s_cbranch_scc1 L_fin
    s_waitcnt vmcnt(1)
    v_xor_b32 v32, s40, v32
    v_xor_b32 v33, s41, v33
    v_xor_b32 v34, s42, v34
    v_xor_b32 v35, s43, v35
    v_or3_b32 v4, v32, v33, v34
    v_bitop3_b32 v4, v4, v35, v19 bitop3:0xa8
    v_cmp_ne_u32 vcc, 0, v4
    v_add_f32_dpp v48, v32, v32 row_ror:1 row_mask:0xf bank_mask:0xf
    v_add_f32_dpp v49, v33, v33 row_ror:1 row_mask:0xf bank_mask:0xf
    v_add_f32_dpp v50, v34, v34 row_ror:1 row_mask:0xf bank_mask:0xf
    v_add_f32_dpp v51, v35, v35 row_ror:1 row_mask:0xf bank_mask:0xf
    s_cbranch_vccz L_gfok
    global_load_dwordx4 v[32:35], v17, s[28:29] sc1
    s_waitcnt vmcnt(1)
    v_xor_b32 v36, s40, v36
    v_xor_b32 v37, s41, v37
    v_xor_b32 v38, s42, v38
    v_xor_b32 v39, s43, v39
    v_or3_b32 v4, v36, v37, v38
    v_bitop3_b32 v4, v4, v39, v19 bitop3:0xa8
    v_cmp_ne_u32 vcc, 0, v4
    v_add_f32_dpp v48, v36, v36 row_ror:1 row_mask:0xf bank_mask:0xf
    v_add_f32_dpp v49, v37, v37 row_ror:1 row_mask:0xf bank_mask:0xf
    v_add_f32_dpp v50, v38, v38 row_ror:1 row_mask:0xf bank_mask:0xf
    v_add_f32_dpp v51, v39, v39 row_ror:1 row_mask:0xf bank_mask:0xf
    s_cbranch_vccnz L_gf
L_gfok:
    v_add_f32_dpp v48, v48, v48 row_ror:2 row_mask:0xf bank_mask:0xf
    v_add_f32_dpp v49, v49, v49 row_ror:2 row_mask:0xf bank_mask:0xf
    v_add_f32_dpp v50, v50, v50 row_ror:2 row_mask:0xf bank_mask:0xf
    v_add_f32_dpp v51, v51, v51 row_ror:2 row_mask:0xf bank_mask:0xf
    v_add_f32_dpp v48, v48, v48 row_ror:4 row_mask:0xf bank_mask:0xf
    v_add_f32_dpp v49, v49, v49 row_ror:4 row_mask:0xf bank_mask:0xf
    v_add_f32_dpp v50, v50, v50 row_ror:4 row_mask:0xf bank_mask:0xf
    v_add_f32_dpp v51, v51, v51 row_ror:4 row_mask:0xf bank_mask:0xf
    v_add_f32_dpp v48, v48, v48 row_ror:8 row_mask:0xf bank_mask:0xf
    v_add_f32_dpp v49, v49, v49 row_ror:8 row_mask:0xf bank_mask:0xf
    v_add_f32_dpp v50, v50, v50 row_ror:8 row_mask:0xf bank_mask:0xf
    v_add_f32_dpp v51, v51, v51 row_ror:8 row_mask:0xf bank_mask:0xf
    v_add_f32_dpp v48, v48, v48 row_bcast:15 row_mask:0xa bank_mask:0xf
    v_add_f32_dpp v49, v49, v49 row_bcast:15 row_mask:0xa bank_mask:0xf
    v_add_f32_dpp v50, v50, v50 row_bcast:15 row_mask:0xa bank_mask:0xf
    v_add_f32_dpp v51, v51, v51 row_bcast:15 row_mask:0xa bank_mask:0xf
    v_cndmask_b32 v48, v48, v50, s[46:47]
    v_cndmask_b32 v49, v49, v51, s[46:47]
    v_cvt_pk_bf16_f32 v48, v48, v49
    v_and_b32 v49, 0xffff0000, v48
    v_add_f32 v49, v49, v10
    v_cvt_pk_bf16_f32 v49, v49, v49
    v_and_b32 v49, 0xffff0000, v49
    v_mul_f32 v50, 0xbfb8aa3b, v49
    v_exp_f32 v50, v50
    v_lshlrev_b32 v48, 16, v48
    v_add_f32 v50, 1.0, v50
    v_rcp_f32 v50, v50
    s_mov_b32 exec_lo, 0x00030000
    v_mul_f32 v49, v49, v50
    v_cvt_pk_bf16_f32 v49, v49, v49
    v_and_b32 v49, 0xffff0000, v49
    v_mul_f32 v48, v48, v49
    v_cvt_pk_bf16_f32 v48, v48, v48
    s_mov_b32 exec_hi, 0x00030000
    v_and_b32 v48, 0xffff0000, v48
    v_add_f32 v48, v48, v9
    v_cvt_pk_bf16_f32 v48, v48, v48
    global_store_short v12, v48, s[24:25]
    s_cmp_lg_u32 s2, 0
    s_cbranch_scc1 L_fin
    v_mov_b32 v4, 0
    v_mov_b32 v5, s37
    s_mov_b64 exec, 0x10000
    global_store_dword v4, v5, s[28:29]
L_fin:
L_exit:
    s_endpgm
.section .rodata,"a"
.p2align 6
.amdhsa_kernel recurrent_scan__sliding_block_cached__mixer_channel_mlp__decode_kernel
  .amdhsa_next_free_vgpr 152
  .amdhsa_next_free_sgpr 98
  .amdhsa_accum_offset 152
  .amdhsa_group_segment_fixed_size 0
  .amdhsa_kernarg_size 104
  .amdhsa_user_sgpr_count 2
  .amdhsa_user_sgpr_kernarg_segment_ptr 1
  .amdhsa_system_sgpr_workgroup_id_x 1
.end_amdhsa_kernel
```
